```python
import torch

def _softmax(x, axis=-1):
    return torch.softmax(x, dim=axis)
def _gelu(x):
    return torch.nn.functional.gelu(x, approximate="tanh")
def _silu(x):
    return torch.nn.functional.silu(x)
def _sigmoid(x):
    return torch.sigmoid(x)
def _layernorm(x, axis=-1, eps=1e-5):
    m = x.mean(dim=axis, keepdim=True)
    v = x.var(dim=axis, keepdim=True, unbiased=False)
    return (x - m) / torch.sqrt(v + eps)
def _scatter_add(tgt, idx, src, axis=0):
    return tgt.clone().index_add_(axis, idx, src)
def _segment_sum(src, seg, n):
    out = torch.zeros((n,) + src.shape[1:], dtype=src.dtype)
    return out.index_add_(0, seg, src)
def _pad(x, pw):
    flat = tuple(v for pair in reversed(pw) for v in pair)
    return torch.nn.functional.pad(x, flat)

kernel_name = 'standalone__glu_gated_swiglu__prompt'

def setup_inputs():

    _w = (lambda a: (lambda t: t.to(torch.bfloat16) if t.is_floating_point() else t)(torch.as_tensor(a)))
    B, S, D, F = 1, 2048, 512, 1376
    return {
        "x": _w((lambda *s: torch.randn(*s, dtype=torch.bfloat16) * 0.05)(B, S, D)),
        "w1": _w((lambda *s: torch.randn(*s, dtype=torch.bfloat16) * 0.05)(D, F) * (2.0 / D) ** 0.5),
        "w3": _w((lambda *s: torch.randn(*s, dtype=torch.bfloat16) * 0.05)(D, F) * (2.0 / D) ** 0.5),
        "w2": _w((lambda *s: torch.randn(*s, dtype=torch.bfloat16) * 0.05)(F, D) * (2.0 / F) ** 0.5),
    }

def reference(x, w1, w3, w2):
    gate = torch.einsum("bsd,df->bsf", x, w1)
    up = torch.einsum("bsd,df->bsf", x, w3)
    h = _silu(gate) * up
    out = torch.einsum("bsf,fd->bsd", h, w2)
    return out
```

```asm
; @launch grid=(256,1,1) block=(512,1,1) lds=163840
.amdgcn_target "amdgcn-amd-amdhsa--gfx950"
.text
.globl standalone__glu_gated_swiglu__prompt_kernel
.p2align 8
.type standalone__glu_gated_swiglu__prompt_kernel,@function
standalone__glu_gated_swiglu__prompt_kernel:
    s_cmp_ge_u32 s2, 256
    s_cbranch_scc1 K_end
    s_load_dwordx2 s[20:21], s[0:1], 0
    s_load_dwordx2 s[24:25], s[0:1], 8
    s_load_dwordx2 s[28:29], s[0:1], 16
    s_load_dwordx2 s[32:33], s[0:1], 24
    s_load_dwordx2 s[40:41], s[0:1], 32
    s_load_dwordx2 s[44:45], s[0:1], 40
    s_load_dwordx2 s[36:37], s[0:1], 48
    v_lshrrev_b32 v2, 6, v0
    v_and_b32 v1, 63, v0
    v_readfirstlane_b32 s48, v2
    s_and_b32 s49, s2, 3
    s_lshl_b32 s49, s49, 2
    s_cmp_lt_u32 s48, 4
    s_cbranch_scc1 K_dec
    s_getpc_b64 s[18:19]
K_pc:
    v_bfe_u32 v60, v0, 1, 7
    v_lshlrev_b32 v60, 7, v60
    v_min_u32 v60, K_codeend-K_pc-4, v60
    global_load_dword v61, v60, s[18:19]
K_dec:
    s_bfe_u32 s50, s2, 65538
    s_bfe_u32 s57, s2, 131075
    s_lshr_b32 s58, s2, 5
    s_add_u32 s51, s49, s57
    s_mul_i32 s52, s50, 7
    s_add_u32 s52, s52, s58
    s_cmp_lg_u32 s58, 7
    s_cbranch_scc1 K_dec2
    s_lshl_b32 s55, s50, 1
    s_and_b32 s56, s57, 1
    s_add_u32 s51, s49, s55
    s_add_u32 s51, s51, s56
    s_lshr_b32 s52, s57, 1
    s_add_u32 s52, s52, 14
K_dec2:
    s_cmp_ge_u32 s48, 4
    s_cbranch_scc1 K_compute
    v_lshrrev_b32 v14, 3, v1
    v_lshrrev_b32 v15, 4, v1
    v_and_b32 v16, 7, v1
    v_xor_b32 v15, v15, v16
    v_lshlrev_b32 v14, 10, v14
    v_lshl_add_u32 v2, v15, 4, v14
    v_xor_b32 v3, 64, v2
    v_add_u32 v3, 7168, v3
    v_add_u32 v4, 14336, v2
    v_add_u32 v5, 14336, v3
    s_bitcmp1_b32 s52, 0
    s_cselect_b32 s55, -64, 64
    s_cselect_b32 s56, 128, 0
    s_cmp_eq_u32 s52, 14
    s_cselect_b32 s55, 2097152, s55
    s_mul_i32 s57, s55, -3
    s_add_u32 s57, s57, 2752
    v_lshrrev_b32 v14, 2, v1
    v_and_b32 v15, 3, v1
    v_lshl_add_u32 v15, v15, 4, s56
    v_and_b32 v16, 32, v1
    v_mul_u32_u24 v17, 43, v14
    v_mov_b32 v18, v15
    v_lshrrev_b32 v17, 7, v17
    v_mad_i32_i24 v18, v14, s55, v18
    v_mad_i32_i24 v6, v17, s57, v18
    v_add_u32 v14, 16, v14
    v_mul_u32_u24 v17, 43, v14
    v_xor_b32 v18, v15, v16
    v_lshrrev_b32 v17, 7, v17
    v_mad_i32_i24 v18, v14, s55, v18
    v_mad_i32_i24 v7, v17, s57, v18
    v_subrev_u32 v7, 1024, v7
    v_add_u32 v14, 16, v14
    v_mul_u32_u24 v17, 43, v14
    v_xor_b32 v18, 32, v15
    v_lshrrev_b32 v17, 7, v17
    v_mad_i32_i24 v18, v14, s55, v18
    v_mad_i32_i24 v8, v17, s57, v18
    v_subrev_u32 v8, 2048, v8
    s_lshl_b32 s64, s48, 12
    s_add_u32 s64, s64, 77824
    s_mul_i32 s65, s48, 6144
    s_add_u32 s65, s65, 94208
    s_lshl_b32 s69, s51, 17
    s_lshl_b32 s55, s48, 15
    s_add_u32 s69, s69, s55
    s_mul_i32 s70, s52, 192
    s_mul_i32 s55, s48, 44032
    s_add_u32 s70, s70, s55
    s_lshl_b32 s60, s50, 1
    s_add_u32 s60, s60, s2
    s_and_b32 s60, s60, 3
    s_lshl_b32 s60, s60, 1
    s_mov_b32 s59, 0
    s_mov_b32 s63, 40960
    s_mov_b32 s22, 2097152
    s_mov_b32 s23, 0x20000
    s_mov_b32 s26, 1409024
    s_mov_b32 s27, 0x20000
    s_mov_b32 s30, 1409024
    s_mov_b32 s31, 0x20000
    s_cmp_ge_u32 s52, 15
    s_cbranch_scc1 K_l_init
    s_lshl_b32 s55, s60, 7
    s_add_u32 s61, s69, s55
    s_mul_i32 s62, s60, 176128
    s_add_u32 s62, s62, s70
    s_mov_b32 m0, s64
    s_waitcnt lgkmcnt(0)
K_l_loop:
    s_mov_b32 m0, s65
    s_add_u32 s60, s60, 1
    buffer_load_dwordx4 v6, s[24:27], s62 offen offset:0 lds
    buffer_load_dwordx4 v7, s[24:27], s62 offen offset:1024 lds
    buffer_load_dwordx4 v8, s[24:27], s62 offen offset:2048 lds
    s_add_u32 m0, m0, 3072
    s_and_b32 s60, s60, 7
    buffer_load_dwordx4 v6, s[28:31], s62 offen offset:0 lds
    buffer_load_dwordx4 v7, s[28:31], s62 offen offset:1024 lds
    buffer_load_dwordx4 v8, s[28:31], s62 offen offset:2048 lds
    s_mov_b32 m0, s64
    s_nop 0
    buffer_load_dwordx4 v2, s[20:23], s61 offen offset:0 lds
    buffer_load_dwordx4 v3, s[20:23], s61 offen offset:1024 lds
    buffer_load_dwordx4 v4, s[20:23], s61 offen offset:2048 lds
    buffer_load_dwordx4 v5, s[20:23], s61 offen offset:3072 lds
    s_lshl_b32 s55, s60, 7
    s_add_u32 s61, s69, s55
    s_mul_i32 s62, s60, 176128
    s_add_u32 s62, s62, s70
    s_cmp_ge_u32 s64, 118784
    s_cselect_b32 s55, 4294885376, s63
    s_add_u32 s64, s64, s55
    s_add_u32 s65, s65, s55
    s_mov_b32 m0, s64
    s_add_u32 s59, s59, 1
    s_cmp_eq_u32 s59, 1
    s_cbranch_scc1 K_l_loop
K_l_init:
    s_lshl_b32 s55, s50, 1
    s_add_u32 s55, s55, s49
    s_lshl_b32 s55, s55, 1
    s_lshr_b32 s56, s2, 6
    s_add_u32 s53, s55, s56
    s_bfe_u32 s54, s2, 196611
    s_mul_i32 s66, s56, 11
    s_mov_b32 s34, 1409024
    s_mov_b32 s35, 0x20000
    s_mov_b32 s38, 8388608
    s_mov_b32 s39, 0x20000
    s_mov_b32 s46, 256
    s_mov_b32 s47, 0x20000
    v_lshrrev_b32 v14, 3, v1
    s_and_b32 s55, s48, 1
    s_lshl_b32 s55, s55, 3
    s_lshr_b32 s56, s48, 1
    s_mul_i32 s56, s56, 688
    s_add_u32 s55, s55, s56
    v_add_u32 v14, s55, v14
    v_lshlrev_b32 v14, 10, v14
    v_lshrrev_b32 v15, 2, v1
    v_and_b32 v15, 4, v15
    v_and_b32 v16, 7, v1
    v_xor_b32 v15, v15, v16
    v_lshl_add_u32 v13, v15, 4, v14
    s_lshl_b32 s80, s54, 7
    s_add_u32 s79, s80, 704512
    s_lshl_b32 s55, s66, 14
    s_add_u32 s78, s80, s55
    s_lshl_b32 s71, s48, 10
    s_lshr_b32 s55, s53, 1
    s_mul_i32 s67, s55, 356352
    s_add_u32 s67, s67, 88064
    v_min_u32 v14, 15, v1
    s_lshl_b32 s81, 1, s52
    s_cmp_eq_u32 s55, s51
    s_cselect_b32 s56, s52, 15
    s_cselect_b32 s81, s81, 0
    v_cmp_eq_u32 vcc, s56, v14
    v_mov_b32 v15, 15
    s_nop 0
    v_cndmask_b32 v14, v14, v15, vcc
    v_lshrrev_b32 v15, 3, v14
    v_mul_u32_u24 v15, 89088, v15
    v_and_b32 v14, 7, v14
    v_lshl_add_u32 v20, v14, 7, v15
    s_waitcnt lgkmcnt(0)
    s_cmp_lg_u32 s48, 0
    s_cbranch_scc1 K_l_nosamp
    buffer_load_dword v21, v20, s[36:39], s67 offen sc1
K_l_nosamp:
    s_cmp_ge_u32 s52, 15
    s_cbranch_scc1 K_l_idle
    s_mov_b32 s75, 0
K_l_wait:
    s_waitcnt vmcnt(10)
    s_barrier
    s_cmp_ge_u32 s59, 8
    s_cbranch_scc1 K_l_tail
    s_mov_b32 m0, s65
    s_add_u32 s60, s60, 1
    buffer_load_dwordx4 v6, s[24:27], s62 offen offset:0 lds
    buffer_load_dwordx4 v7, s[24:27], s62 offen offset:1024 lds
    buffer_load_dwordx4 v8, s[24:27], s62 offen offset:2048 lds
    s_add_u32 m0, m0, 3072
    s_and_b32 s60, s60, 7
    buffer_load_dwordx4 v6, s[28:31], s62 offen offset:0 lds
    buffer_load_dwordx4 v7, s[28:31], s62 offen offset:1024 lds
    buffer_load_dwordx4 v8, s[28:31], s62 offen offset:2048 lds
    s_mov_b32 m0, s64
    s_nop 0
    buffer_load_dwordx4 v2, s[20:23], s61 offen offset:0 lds
    buffer_load_dwordx4 v3, s[20:23], s61 offen offset:1024 lds
    buffer_load_dwordx4 v4, s[20:23], s61 offen offset:2048 lds
    buffer_load_dwordx4 v5, s[20:23], s61 offen offset:3072 lds
    s_lshl_b32 s55, s60, 7
    s_add_u32 s61, s69, s55
    s_mul_i32 s62, s60, 176128
    s_add_u32 s62, s62, s70
    s_cmp_ge_u32 s64, 118784
    s_cselect_b32 s55, 4294885376, s63
    s_add_u32 s64, s64, s55
    s_add_u32 s65, s65, s55
    s_mov_b32 m0, s64
    s_add_u32 s59, s59, 1
    s_branch K_l_wait
K_compute:
    s_setprio 1
    s_and_b32 s55, s48, 1
    s_lshl_b32 s55, s55, 13
    s_add_u32 s55, s55, 77824
    v_and_b32 v10, 15, v1
    v_lshrrev_b32 v11, 1, v10
    v_lshrrev_b32 v12, 4, v1
    v_lshl_add_u32 v10, v10, 7, s55
    v_xor_b32 v13, v12, v11
    v_and_b32 v11, 1, v12
    v_lshl_add_u32 v2, v13, 4, v10
    v_xor_b32 v3, 64, v2
    v_lshrrev_b32 v10, 1, v12
    v_bfe_u32 v12, v1, 2, 2
    v_lshl_add_u32 v12, v11, 3, v12
    v_mul_u32_u24 v12, 192, v12
    v_mul_u32_u24 v13, 6144, v10
    v_and_b32 v10, 3, v1
    v_lshl_add_u32 v12, v10, 3, v12
    s_mov_b32 s56, 94208
    v_add3_u32 v12, v12, v13, s56
    v_lshlrev_b32 v11, 5, v11
    s_bfe_u32 s55, s48, 65537
    s_lshl_b32 s56, s55, 5
    s_lshl_b32 s57, s55, 6
    v_xor_b32 v13, s56, v11
    v_add3_u32 v6, v12, v13, s57
    v_add_u32 v8, 64, v6
    v_xor_b32 v13, 32, v13
    s_lshl_b32 s57, s55, 7
    v_add3_u32 v7, v12, v13, s57
    v_mov_b32 v21, 0
    v_mov_b32 v22, 159744
    ds_write_b32 v22, v21
    ds_write_b32 v22, v21 offset:4
    v_mov_b32 v23, 1
    v_mov_b64 v[64:65], 0
    v_mov_b64 v[66:67], 0
    v_mov_b64 v[68:69], 0
    v_mov_b64 v[70:71], 0
    v_mov_b64 v[72:73], 0
    v_mov_b64 v[74:75], 0
    v_mov_b64 v[76:77], 0
    v_mov_b64 v[78:79], 0
    v_mov_b64 v[80:81], 0
    v_mov_b64 v[82:83], 0
    v_mov_b64 v[84:85], 0
    v_mov_b64 v[86:87], 0
    v_mov_b64 v[88:89], 0
    v_mov_b64 v[90:91], 0
    v_mov_b64 v[92:93], 0
    v_mov_b64 v[94:95], 0
    v_mov_b64 v[96:97], 0
    v_mov_b64 v[98:99], 0
    v_mov_b64 v[100:101], 0
    v_mov_b64 v[102:103], 0
    v_mov_b64 v[104:105], 0
    v_mov_b64 v[106:107], 0
    v_mov_b64 v[108:109], 0
    v_mov_b64 v[110:111], 0
    v_mov_b64 v[112:113], 0
    v_mov_b64 v[114:115], 0
    v_mov_b64 v[116:117], 0
    v_mov_b64 v[118:119], 0
    v_mov_b64 v[120:121], 0
    v_mov_b64 v[122:123], 0
    v_mov_b64 v[124:125], 0
    v_mov_b64 v[126:127], 0
    v_mov_b64 v[128:129], 0
    v_mov_b64 v[130:131], 0
    v_mov_b64 v[132:133], 0
    v_mov_b64 v[134:135], 0
    v_mov_b64 v[136:137], 0
    v_mov_b64 v[138:139], 0
    v_mov_b64 v[140:141], 0
    v_mov_b64 v[142:143], 0
    v_mov_b64 v[144:145], 0
    v_mov_b64 v[146:147], 0
    v_mov_b64 v[148:149], 0
    v_mov_b64 v[150:151], 0
    v_mov_b64 v[152:153], 0
    v_mov_b64 v[154:155], 0
    v_mov_b64 v[156:157], 0
    v_mov_b64 v[158:159], 0
    s_cmp_eq_u32 s55, 0
    s_cselect_b32 s56, 2, 0
    s_movk_i32 s57, 0x543
    s_cselect_b32 s57, 0x210, s57
    s_movk_i32 s58, 0x103
    s_cselect_b32 s58, 0x254, s58
    s_cmp_eq_u32 s52, 14
    s_cselect_b32 s81, s56, 3
    s_bitcmp1_b32 s52, 0
    s_cselect_b32 s57, s58, s57
    s_and_b32 s56, s48, 1
    s_lshl_b32 s58, s51, 1
    s_add_u32 s56, s56, s58
    s_mul_i32 s56, s56, 174
    s_mul_i32 s58, s52, 6
    s_add_u32 s56, s56, s58
    s_bfe_u32 s58, s57, 262144
    s_add_u32 s58, s58, s56
    s_lshl_b32 s72, s58, 10
    s_bfe_u32 s58, s57, 262148
    s_add_u32 s58, s58, s56
    s_lshl_b32 s73, s58, 10
    s_bfe_u32 s58, s57, 262152
    s_add_u32 s58, s58, s56
    s_lshl_b32 s74, s58, 10
    s_mov_b32 s68, 0xbfb8aa3b
    v_lshlrev_b32 v9, 4, v1
    v_add_u32 v10, 89088, v9
    v_mov_b32 v56, s68
    v_mov_b32 v57, s68
    v_mov_b32 v58, 1.0
    v_mov_b32 v59, 1.0
    s_mov_b32 s38, 8388608
    s_mov_b32 s39, 0x20000
    s_mov_b32 s42, 2097152
    s_mov_b32 s43, 0x20000
    s_mov_b32 s59, 0
    s_mov_b32 s63, 1
    s_mov_b32 s61, 40960
    s_waitcnt lgkmcnt(0)
    s_cmp_ge_u32 s52, 15
    s_cbranch_scc1 K_c_idle
    s_cmp_eq_u32 s81, 0
    s_cbranch_scc1 K_c_lazy
    s_branch K_pg1
K_c_lazy:
    s_barrier
    s_barrier
    s_barrier
    s_barrier
    s_barrier
    s_barrier
    s_barrier
    s_barrier
    s_branch K_c_epidone
K_c_idle:
    s_mov_b32 s22, 2097152
    s_mov_b32 s23, 0x20000
    s_mov_b32 s34, 1409024
    s_mov_b32 s35, 0x20000
    s_bfe_u32 s57, s2, 65539
    s_lshl_b32 s60, s50, 1
    s_add_u32 s60, s60, s2
    s_and_b32 s60, s60, 3
    s_lshl_b32 s60, s60, 1
    v_lshlrev_b32 v40, 10, v1
    s_lshl_b32 s55, s49, 17
    s_lshl_b32 s56, s48, 16
    s_add_u32 s55, s55, s56
    s_add_u32 s56, s60, s57
    s_add_u32 s56, s56, 2
    s_and_b32 s56, s56, 7
    s_lshl_b32 s56, s56, 7
    s_add_u32 s55, s55, s56
    buffer_load_dword v42, v40, s[20:23], s55 offen
    v_min_u32 v44, 42, v1
    v_lshlrev_b32 v44, 10, v44
    s_mul_i32 s55, s57, 688
    s_mul_i32 s56, s48, 86
    s_add_u32 s55, s55, s56
    s_lshl_b32 s55, s55, 10
    buffer_load_dword v45, v44, s[32:35], s55 offen offset:384
    s_add_u32 s55, s55, 44032
    buffer_load_dword v45, v44, s[32:35], s55 offen offset:384
    s_branch K_c_epidone
K_l_tail:
    s_add_u32 m0, s71, 0
    v_mov_b32 v17, 159744
    s_cmp_ge_u32 s75, 8
    s_cbranch_scc1 K_l_w0e
K_l_w0:
    buffer_load_dwordx4 v13, s[32:35], s78 offen lds
    s_add_u32 s78, s78, 16384
    s_cmp_eq_u32 s78, s79
    s_cselect_b32 s78, s80, s78
    s_add_u32 m0, m0, 4096
    s_add_u32 s75, s75, 1
    s_cmp_lt_u32 s75, 8
    s_cbranch_scc1 K_l_w0
K_l_w0e:
    s_waitcnt vmcnt(8)
    s_barrier
    s_cmp_ge_u32 s75, 20
    s_cbranch_scc1 K_l_w1e
K_l_w1:
    s_waitcnt vmcnt(12)
    buffer_load_dwordx4 v13, s[32:35], s78 offen lds
    s_add_u32 s78, s78, 16384
    s_cmp_eq_u32 s78, s79
    s_cselect_b32 s78, s80, s78
    s_add_u32 m0, m0, 4096
    s_add_u32 s75, s75, 1
    s_cmp_lt_u32 s75, 20
    s_cbranch_scc1 K_l_w1
K_l_w1e:
K_l_stop:
    s_mul_i32 s69, s51, 356352
    s_lshr_b32 s56, s52, 3
    s_mul_i32 s56, s56, 89088
    s_add_u32 s69, s69, s56
    s_and_b32 s56, s52, 7
    s_lshl_b32 s56, s56, 7
    s_add_u32 s69, s69, s56
    s_add_u32 s69, s69, 88064
    s_mov_b32 s70, 1
    s_waitcnt vmcnt(0)
    s_add_u32 s76, s75, 10
    s_min_u32 s76, s76, 39
K_l_last:
    ds_read_b32 v18, v17 offset:4
    s_waitcnt lgkmcnt(0)
    v_readfirstlane_b32 s55, v18
    s_nop 0
    s_cmp_lt_u32 s55, 4
    s_cbranch_scc1 K_l_last
    s_cmp_ge_u32 s75, s76
    s_cbranch_scc1 K_l_w2e
K_l_w2:
    buffer_load_dwordx4 v13, s[32:35], s78 offen lds
    s_add_u32 s78, s78, 16384
    s_cmp_eq_u32 s78, s79
    s_cselect_b32 s78, s80, s78
    s_add_u32 m0, m0, 4096
    s_add_u32 s75, s75, 1
    s_cmp_lt_u32 s75, s76
    s_cbranch_scc1 K_l_w2
K_l_w2e:
    s_cmp_lg_u32 s48, 2
    s_barrier
    s_cbranch_scc1 K_l_nofl
    s_atomic_add s70, s[36:37], s69
K_l_nofl:
    s_branch K_l_bb
K_l_idle:
    s_bfe_u32 s57, s2, 65539
    s_lshl_b32 s60, s50, 1
    s_add_u32 s60, s60, s2
    s_and_b32 s60, s60, 3
    s_lshl_b32 s60, s60, 1
    v_lshlrev_b32 v40, 10, v1
    s_lshl_b32 s55, s49, 17
    s_lshl_b32 s56, s48, 16
    s_add_u32 s55, s55, s56
    s_add_u32 s56, s60, s57
    s_add_u32 s56, s56, 2
    s_and_b32 s56, s56, 7
    s_lshl_b32 s56, s56, 7
    s_add_u32 s55, s55, s56
    buffer_load_dword v42, v40, s[20:23], s55 offen
    v_min_u32 v44, 42, v1
    v_lshlrev_b32 v44, 10, v44
    s_mul_i32 s55, s57, 688
    s_mul_i32 s56, s48, 86
    s_add_u32 s55, s55, s56
    s_lshl_b32 s55, s55, 10
    buffer_load_dword v45, v44, s[32:35], s55 offen offset:384
    s_add_u32 s55, s55, 44032
    buffer_load_dword v45, v44, s[32:35], s55 offen offset:384
    s_mov_b32 m0, s71
    s_mov_b32 s75, 0
    s_cmp_ge_u32 s75, 39
    s_cbranch_scc1 K_l_w3e
K_l_w3:
    buffer_load_dwordx4 v13, s[32:35], s78 offen lds
    s_add_u32 s78, s78, 16384
    s_cmp_eq_u32 s78, s79
    s_cselect_b32 s78, s80, s78
    s_add_u32 m0, m0, 4096
    s_add_u32 s75, s75, 1
    s_cmp_lt_u32 s75, 39
    s_cbranch_scc1 K_l_w3
K_l_w3e:
    s_waitcnt vmcnt(0)
    s_barrier
K_l_bb:
    s_barrier
    s_cmp_ge_u32 s75, 39
    s_cbranch_scc1 K_l_w4e
K_l_w4:
    buffer_load_dwordx4 v13, s[32:35], s78 offen lds
    s_add_u32 s78, s78, 16384
    s_cmp_eq_u32 s78, s79
    s_cselect_b32 s78, s80, s78
    s_add_u32 m0, m0, 4096
    s_add_u32 s75, s75, 1
    s_cmp_lt_u32 s75, 39
    s_cbranch_scc1 K_l_w4
K_l_w4e:
    s_mov_b32 m0, s71
    s_cmp_ge_u32 s75, 43
    s_cbranch_scc1 K_l_w5e
K_l_w5:
    buffer_load_dwordx4 v13, s[32:35], s78 offen lds
    s_add_u32 s78, s78, 16384
    s_cmp_eq_u32 s78, s79
    s_cselect_b32 s78, s80, s78
    s_add_u32 m0, m0, 4096
    s_add_u32 s75, s75, 1
    s_cmp_lt_u32 s75, 43
    s_cbranch_scc1 K_l_w5
K_l_w5e:
    s_cmp_lg_u32 s48, 1
    s_cbranch_scc1 K_l_nofb
    s_cmp_ge_u32 s52, 15
    s_cbranch_scc1 K_l_nofb
    s_lshl_b32 s61, 1, s52
    s_lshl_b32 s62, s51, 4
    s_atomic_add s61, s[44:45], s62
K_l_nofb:
K_l_sel:
    s_cmp_lg_u32 s48, 0
    s_cbranch_scc1 K_l_go
    s_lshr_b32 s56, s53, 1
    s_lshl_b32 s56, s56, 4
    v_mov_b32 v18, 0
    v_mov_b32 v17, 159744
    v_mov_b32 v19, 1
    s_mov_b32 s59, 0
K_l_poll:
    buffer_load_dword v22, v20, s[36:39], s67 offen sc1
    s_add_u32 s59, s59, 1
    s_waitcnt vmcnt(0)
    v_cmp_ne_u32 vcc, v22, v21
    s_and_b32 s55, s59, 31
    s_or_b32 s57, vcc_lo, s81
    s_and_b32 s57, s57, 0x7fff
    s_cmp_eq_u32 s57, 0x7fff
    s_cbranch_scc1 K_l_ok
    s_cmp_lg_u32 s55, 0
    s_cbranch_scc1 K_l_poll
    buffer_load_dword v16, v18, s[44:47], s56 offen sc1
    s_waitcnt vmcnt(0)
    v_readfirstlane_b32 s55, v16
    s_cmp_ge_u32 s59, 4000000
    s_cbranch_scc1 K_l_ok
    s_or_b32 s57, s57, s55
    s_cmp_lg_u32 s57, 0x7fff
    s_cbranch_scc1 K_l_poll
K_l_ok:
    ds_write_b32 v17, v19
K_l_go:
    s_waitcnt vmcnt(0)
    s_barrier
K_end:
    s_endpgm
.p2align 12
K_pg1:
    s_barrier
    ds_read_b128 v[160:163], v2 offset:0
    ds_read_b64_tr_b16 v[176:177], v6 offset:0
    ds_read_b64_tr_b16 v[178:179], v6 offset:768
    ds_read_b128 v[164:167], v2 offset:2048
    ds_read_b64_tr_b16 v[180:181], v6 offset:3072
    ds_read_b64_tr_b16 v[182:183], v6 offset:3840
    ds_read_b128 v[168:171], v2 offset:4096
    ds_read_b128 v[172:175], v2 offset:6144
    ds_read_b64_tr_b16 v[184:185], v7 offset:0
    ds_read_b64_tr_b16 v[186:187], v7 offset:768
    ds_read_b64_tr_b16 v[188:189], v7 offset:3072
    ds_read_b64_tr_b16 v[190:191], v7 offset:3840
    s_waitcnt lgkmcnt(8)
    ds_read_b64_tr_b16 v[192:193], v8 offset:0
    ds_read_b64_tr_b16 v[194:195], v8 offset:768
    ds_read_b64_tr_b16 v[196:197], v8 offset:3072
    ds_read_b64_tr_b16 v[198:199], v8 offset:3840
K_c_loop:
    s_waitcnt lgkmcnt(8)
    v_mfma_f32_16x16x32_bf16 v[64:67], v[176:179], v[160:163], v[64:67]
    ds_read_b128 v[200:203], v3 offset:0
    v_mfma_f32_16x16x32_bf16 v[68:71], v[176:179], v[164:167], v[68:71]
    ds_read_b64_tr_b16 v[216:217], v6 offset:12288
    v_mfma_f32_16x16x32_bf16 v[72:75], v[176:179], v[168:171], v[72:75]
    ds_read_b64_tr_b16 v[218:219], v6 offset:13056
    v_mfma_f32_16x16x32_bf16 v[76:79], v[176:179], v[172:175], v[76:79]
    ds_read_b128 v[204:207], v3 offset:2048
    v_mfma_f32_16x16x32_bf16 v[92:95], v[180:183], v[172:175], v[92:95]
    ds_read_b64_tr_b16 v[220:221], v6 offset:15360
    v_mfma_f32_16x16x32_bf16 v[88:91], v[180:183], v[168:171], v[88:91]
    ds_read_b64_tr_b16 v[222:223], v6 offset:16128
    v_mfma_f32_16x16x32_bf16 v[84:87], v[180:183], v[164:167], v[84:87]
    ds_read_b128 v[208:211], v3 offset:4096
    v_mfma_f32_16x16x32_bf16 v[80:83], v[180:183], v[160:163], v[80:83]
    ds_read_b128 v[212:215], v3 offset:6144
    s_waitcnt lgkmcnt(14)
    v_mfma_f32_16x16x32_bf16 v[96:99], v[184:187], v[160:163], v[96:99]
    ds_read_b64_tr_b16 v[224:225], v7 offset:12288
    v_mfma_f32_16x16x32_bf16 v[100:103], v[184:187], v[164:167], v[100:103]
    ds_read_b64_tr_b16 v[226:227], v7 offset:13056
    v_mfma_f32_16x16x32_bf16 v[104:107], v[184:187], v[168:171], v[104:107]
    ds_read_b64_tr_b16 v[228:229], v7 offset:15360
    v_mfma_f32_16x16x32_bf16 v[108:111], v[184:187], v[172:175], v[108:111]
    ds_read_b64_tr_b16 v[230:231], v7 offset:16128
    s_waitcnt lgkmcnt(15)
    v_mfma_f32_16x16x32_bf16 v[124:127], v[188:191], v[172:175], v[124:127]
    ds_read_b64_tr_b16 v[232:233], v8 offset:12288
    v_mfma_f32_16x16x32_bf16 v[120:123], v[188:191], v[168:171], v[120:123]
    ds_read_b64_tr_b16 v[234:235], v8 offset:13056
    v_mfma_f32_16x16x32_bf16 v[116:119], v[188:191], v[164:167], v[116:119]
    ds_read_b64_tr_b16 v[236:237], v8 offset:15360
    v_mfma_f32_16x16x32_bf16 v[112:115], v[188:191], v[160:163], v[112:115]
    ds_read_b64_tr_b16 v[238:239], v8 offset:16128
    s_waitcnt lgkmcnt(15)
    v_mfma_f32_16x16x32_bf16 v[128:131], v[192:195], v[160:163], v[128:131]
    s_add_u32 s63, s63, 1
    s_cmp_eq_u32 s63, 3
    v_mfma_f32_16x16x32_bf16 v[132:135], v[192:195], v[164:167], v[132:135]
    s_cselect_b32 s55, 4294885376, s61
    s_cselect_b32 s63, 0, s63
    v_mfma_f32_16x16x32_bf16 v[136:139], v[192:195], v[168:171], v[136:139]
    s_add_u32 s59, s59, 1
    v_mfma_f32_16x16x32_bf16 v[140:143], v[192:195], v[172:175], v[140:143]
    v_add_u32 v2, s55, v2
    s_waitcnt lgkmcnt(15)
    v_mfma_f32_16x16x32_bf16 v[156:159], v[196:199], v[172:175], v[156:159]
    v_add_u32 v3, s55, v3
    v_mfma_f32_16x16x32_bf16 v[152:155], v[196:199], v[168:171], v[152:155]
    v_add_u32 v6, s55, v6
    v_mfma_f32_16x16x32_bf16 v[148:151], v[196:199], v[164:167], v[148:151]
    v_add_u32 v7, s55, v7
    v_mfma_f32_16x16x32_bf16 v[144:147], v[196:199], v[160:163], v[144:147]
    v_add_u32 v8, s55, v8
    s_waitcnt lgkmcnt(0)
    v_mfma_f32_16x16x32_bf16 v[64:67], v[216:219], v[200:203], v[64:67]
    v_mfma_f32_16x16x32_bf16 v[68:71], v[216:219], v[204:207], v[68:71]
    v_mfma_f32_16x16x32_bf16 v[72:75], v[216:219], v[208:211], v[72:75]
    v_mfma_f32_16x16x32_bf16 v[76:79], v[216:219], v[212:215], v[76:79]
    v_mfma_f32_16x16x32_bf16 v[92:95], v[220:223], v[212:215], v[92:95]
    v_mfma_f32_16x16x32_bf16 v[88:91], v[220:223], v[208:211], v[88:91]
    v_mfma_f32_16x16x32_bf16 v[84:87], v[220:223], v[204:207], v[84:87]
    v_mfma_f32_16x16x32_bf16 v[80:83], v[220:223], v[200:203], v[80:83]
    v_mfma_f32_16x16x32_bf16 v[96:99], v[224:227], v[200:203], v[96:99]
    v_mfma_f32_16x16x32_bf16 v[100:103], v[224:227], v[204:207], v[100:103]
    v_mfma_f32_16x16x32_bf16 v[104:107], v[224:227], v[208:211], v[104:107]
    v_mfma_f32_16x16x32_bf16 v[108:111], v[224:227], v[212:215], v[108:111]
    v_mfma_f32_16x16x32_bf16 v[124:127], v[228:231], v[212:215], v[124:127]
    v_mfma_f32_16x16x32_bf16 v[120:123], v[228:231], v[208:211], v[120:123]
    v_mfma_f32_16x16x32_bf16 v[116:119], v[228:231], v[204:207], v[116:119]
    v_mfma_f32_16x16x32_bf16 v[112:115], v[228:231], v[200:203], v[112:115]
    s_barrier
    v_mfma_f32_16x16x32_bf16 v[128:131], v[232:235], v[200:203], v[128:131]
    ds_read_b128 v[160:163], v2 offset:0
    ds_read_b64_tr_b16 v[176:177], v6 offset:0
    v_mfma_f32_16x16x32_bf16 v[132:135], v[232:235], v[204:207], v[132:135]
    ds_read_b64_tr_b16 v[178:179], v6 offset:768
    ds_read_b128 v[164:167], v2 offset:2048
    v_mfma_f32_16x16x32_bf16 v[136:139], v[232:235], v[208:211], v[136:139]
    ds_read_b64_tr_b16 v[180:181], v6 offset:3072
    ds_read_b64_tr_b16 v[182:183], v6 offset:3840
    v_mfma_f32_16x16x32_bf16 v[140:143], v[232:235], v[212:215], v[140:143]
    ds_read_b128 v[168:171], v2 offset:4096
    ds_read_b128 v[172:175], v2 offset:6144
    v_mfma_f32_16x16x32_bf16 v[156:159], v[236:239], v[212:215], v[156:159]
    ds_read_b64_tr_b16 v[184:185], v7 offset:0
    ds_read_b64_tr_b16 v[186:187], v7 offset:768
    v_mfma_f32_16x16x32_bf16 v[152:155], v[236:239], v[208:211], v[152:155]
    ds_read_b64_tr_b16 v[188:189], v7 offset:3072
    ds_read_b64_tr_b16 v[190:191], v7 offset:3840
    v_mfma_f32_16x16x32_bf16 v[148:151], v[236:239], v[204:207], v[148:151]
    ds_read_b64_tr_b16 v[192:193], v8 offset:0
    ds_read_b64_tr_b16 v[194:195], v8 offset:768
    v_mfma_f32_16x16x32_bf16 v[144:147], v[236:239], v[200:203], v[144:147]
    ds_read_b64_tr_b16 v[196:197], v8 offset:3072
    ds_read_b64_tr_b16 v[198:199], v8 offset:3840
    s_cmp_lt_u32 s59, 7
    s_cbranch_scc1 K_c_loop
    s_waitcnt lgkmcnt(8)
    v_mfma_f32_16x16x32_bf16 v[64:67], v[176:179], v[160:163], v[64:67]
    ds_read_b128 v[200:203], v3 offset:0
    ds_read_b64_tr_b16 v[216:217], v6 offset:12288
    v_mfma_f32_16x16x32_bf16 v[68:71], v[176:179], v[164:167], v[68:71]
    ds_read_b64_tr_b16 v[218:219], v6 offset:13056
    ds_read_b128 v[204:207], v3 offset:2048
    v_mfma_f32_16x16x32_bf16 v[80:83], v[180:183], v[160:163], v[80:83]
    ds_read_b64_tr_b16 v[220:221], v6 offset:15360
    ds_read_b64_tr_b16 v[222:223], v6 offset:16128
    v_mfma_f32_16x16x32_bf16 v[84:87], v[180:183], v[164:167], v[84:87]
    s_waitcnt lgkmcnt(6)
    ds_read_b128 v[208:211], v3 offset:4096
    ds_read_b128 v[212:215], v3 offset:6144
    v_mfma_f32_16x16x32_bf16 v[72:75], v[176:179], v[168:171], v[72:75]
    ds_read_b64_tr_b16 v[224:225], v7 offset:12288
    ds_read_b64_tr_b16 v[226:227], v7 offset:13056
    v_mfma_f32_16x16x32_bf16 v[76:79], v[176:179], v[172:175], v[76:79]
    ds_read_b64_tr_b16 v[228:229], v7 offset:15360
    ds_read_b64_tr_b16 v[230:231], v7 offset:16128
    v_mfma_f32_16x16x32_bf16 v[88:91], v[180:183], v[168:171], v[88:91]
    ds_read_b64_tr_b16 v[232:233], v8 offset:12288
    ds_read_b64_tr_b16 v[234:235], v8 offset:13056
    v_mfma_f32_16x16x32_bf16 v[92:95], v[180:183], v[172:175], v[92:95]
    ds_read_b64_tr_b16 v[236:237], v8 offset:15360
    s_waitcnt lgkmcnt(9)
    ds_read_b64_tr_b16 v[238:239], v8 offset:16128
    s_waitcnt lgkmcnt(8)
    v_mfma_f32_16x16x32_bf16 v[64:67], v[216:219], v[200:203], v[64:67]
    v_mfma_f32_16x16x32_bf16 v[68:71], v[216:219], v[204:207], v[68:71]
    v_mfma_f32_16x16x32_bf16 v[80:83], v[220:223], v[200:203], v[80:83]
    v_mfma_f32_16x16x32_bf16 v[84:87], v[220:223], v[204:207], v[84:87]
    v_mfma_f32_16x16x32_bf16 v[72:75], v[216:219], v[208:211], v[72:75]
    v_mfma_f32_16x16x32_bf16 v[76:79], v[216:219], v[212:215], v[76:79]
    v_mfma_f32_16x16x32_bf16 v[88:91], v[220:223], v[208:211], v[88:91]
    v_mfma_f32_16x16x32_bf16 v[92:95], v[220:223], v[212:215], v[92:95]
    s_nop 5
    v_mul_f32 v32, s68, v64
    v_mul_f32 v33, s68, v65
    s_waitcnt lgkmcnt(0)
    v_mfma_f32_16x16x32_bf16 v[96:99], v[184:187], v[160:163], v[96:99]
    v_mul_f32 v34, s68, v66
    v_mul_f32 v35, s68, v67
    v_mfma_f32_16x16x32_bf16 v[100:103], v[184:187], v[164:167], v[100:103]
    v_mul_f32 v36, s68, v68
    v_mul_f32 v37, s68, v69
    v_mfma_f32_16x16x32_bf16 v[112:115], v[188:191], v[160:163], v[112:115]
    v_mul_f32 v38, s68, v70
    v_mul_f32 v39, s68, v71
    v_mfma_f32_16x16x32_bf16 v[116:119], v[188:191], v[164:167], v[116:119]
    v_exp_f32 v32, v32
    v_mfma_f32_16x16x32_bf16 v[96:99], v[224:227], v[200:203], v[96:99]
    v_exp_f32 v33, v33
    v_mfma_f32_16x16x32_bf16 v[100:103], v[224:227], v[204:207], v[100:103]
    v_exp_f32 v34, v34
    v_mfma_f32_16x16x32_bf16 v[112:115], v[228:231], v[200:203], v[112:115]
    v_exp_f32 v35, v35
    v_mfma_f32_16x16x32_bf16 v[116:119], v[228:231], v[204:207], v[116:119]
    v_exp_f32 v36, v36
    v_mfma_f32_16x16x32_bf16 v[104:107], v[184:187], v[168:171], v[104:107]
    v_exp_f32 v37, v37
    v_mfma_f32_16x16x32_bf16 v[108:111], v[184:187], v[172:175], v[108:111]
    v_exp_f32 v38, v38
    v_mfma_f32_16x16x32_bf16 v[120:123], v[188:191], v[168:171], v[120:123]
    v_exp_f32 v39, v39
    v_mfma_f32_16x16x32_bf16 v[124:127], v[188:191], v[172:175], v[124:127]
    v_add_f32 v32, 1.0, v32
    v_add_f32 v33, 1.0, v33
    v_mfma_f32_16x16x32_bf16 v[104:107], v[224:227], v[208:211], v[104:107]
    v_add_f32 v34, 1.0, v34
    v_add_f32 v35, 1.0, v35
    v_mfma_f32_16x16x32_bf16 v[108:111], v[224:227], v[212:215], v[108:111]
    v_add_f32 v36, 1.0, v36
    v_add_f32 v37, 1.0, v37
    v_mfma_f32_16x16x32_bf16 v[120:123], v[228:231], v[208:211], v[120:123]
    v_add_f32 v38, 1.0, v38
    v_add_f32 v39, 1.0, v39
    v_mfma_f32_16x16x32_bf16 v[124:127], v[228:231], v[212:215], v[124:127]
    v_rcp_f32 v32, v32
    v_mfma_f32_16x16x32_bf16 v[128:131], v[192:195], v[160:163], v[128:131]
    v_rcp_f32 v33, v33
    v_mfma_f32_16x16x32_bf16 v[132:135], v[192:195], v[164:167], v[132:135]
    v_rcp_f32 v34, v34
    v_mfma_f32_16x16x32_bf16 v[144:147], v[196:199], v[160:163], v[144:147]
    v_rcp_f32 v35, v35
    v_mfma_f32_16x16x32_bf16 v[148:151], v[196:199], v[164:167], v[148:151]
    v_rcp_f32 v36, v36
    v_mfma_f32_16x16x32_bf16 v[128:131], v[232:235], v[200:203], v[128:131]
    v_rcp_f32 v37, v37
    v_mfma_f32_16x16x32_bf16 v[132:135], v[232:235], v[204:207], v[132:135]
    v_rcp_f32 v38, v38
    v_mfma_f32_16x16x32_bf16 v[144:147], v[236:239], v[200:203], v[144:147]
    v_rcp_f32 v39, v39
    v_mfma_f32_16x16x32_bf16 v[148:151], v[236:239], v[204:207], v[148:151]
    v_mul_f32 v32, v32, v64
    v_mul_f32 v33, v33, v65
    v_mfma_f32_16x16x32_bf16 v[136:139], v[192:195], v[168:171], v[136:139]
    v_mul_f32 v34, v34, v66
    v_mul_f32 v35, v35, v67
    v_mfma_f32_16x16x32_bf16 v[140:143], v[192:195], v[172:175], v[140:143]
    v_mul_f32 v36, v36, v68
    v_mul_f32 v37, v37, v69
    v_mfma_f32_16x16x32_bf16 v[152:155], v[196:199], v[168:171], v[152:155]
    v_mul_f32 v38, v38, v70
    v_mul_f32 v39, v39, v71
    v_mfma_f32_16x16x32_bf16 v[156:159], v[196:199], v[172:175], v[156:159]
    v_mul_f32 v32, v32, v80
    v_mul_f32 v33, v33, v81
    v_mfma_f32_16x16x32_bf16 v[136:139], v[232:235], v[208:211], v[136:139]
    v_mul_f32 v34, v34, v82
    v_mul_f32 v35, v35, v83
    v_mfma_f32_16x16x32_bf16 v[140:143], v[232:235], v[212:215], v[140:143]
    v_mul_f32 v36, v36, v84
    v_mul_f32 v37, v37, v85
    v_mfma_f32_16x16x32_bf16 v[152:155], v[236:239], v[208:211], v[152:155]
    v_mul_f32 v38, v38, v86
    v_mul_f32 v39, v39, v87
    v_mfma_f32_16x16x32_bf16 v[156:159], v[236:239], v[212:215], v[156:159]
    v_cvt_pk_bf16_f32 v40, v32, v33
    v_cvt_pk_bf16_f32 v42, v36, v37
    v_cvt_pk_bf16_f32 v41, v34, v35
    v_cvt_pk_bf16_f32 v43, v38, v39
    v_permlane16_swap_b32 v40, v42
    s_nop 0
    v_permlane16_swap_b32 v41, v43
    buffer_store_dwordx4 v[40:43], v9, s[36:39], s72 offen sc1
    v_pk_mul_f32 v[44:45], v[72:73], v[56:57]
    v_pk_mul_f32 v[46:47], v[74:75], v[56:57]
    v_pk_mul_f32 v[48:49], v[76:77], v[56:57]
    v_pk_mul_f32 v[50:51], v[78:79], v[56:57]
    v_exp_f32 v44, v44
    v_exp_f32 v45, v45
    v_exp_f32 v46, v46
    v_exp_f32 v47, v47
    v_exp_f32 v48, v48
    v_exp_f32 v49, v49
    v_exp_f32 v50, v50
    v_exp_f32 v51, v51
    v_pk_add_f32 v[44:45], v[44:45], v[58:59]
    v_pk_add_f32 v[46:47], v[46:47], v[58:59]
    v_pk_add_f32 v[48:49], v[48:49], v[58:59]
    v_pk_add_f32 v[50:51], v[50:51], v[58:59]
    v_rcp_f32 v44, v44
    v_rcp_f32 v45, v45
    v_rcp_f32 v46, v46
    v_rcp_f32 v47, v47
    v_rcp_f32 v48, v48
    v_rcp_f32 v49, v49
    v_rcp_f32 v50, v50
    v_rcp_f32 v51, v51
    v_pk_mul_f32 v[44:45], v[44:45], v[72:73]
    v_pk_mul_f32 v[46:47], v[46:47], v[74:75]
    v_pk_mul_f32 v[48:49], v[48:49], v[76:77]
    v_pk_mul_f32 v[50:51], v[50:51], v[78:79]
    v_pk_mul_f32 v[44:45], v[44:45], v[88:89]
    v_pk_mul_f32 v[46:47], v[46:47], v[90:91]
    v_pk_mul_f32 v[48:49], v[48:49], v[92:93]
    v_pk_mul_f32 v[50:51], v[50:51], v[94:95]
    v_cvt_pk_bf16_f32 v52, v44, v45
    v_cvt_pk_bf16_f32 v54, v48, v49
    v_cvt_pk_bf16_f32 v53, v46, v47
    v_cvt_pk_bf16_f32 v55, v50, v51
    v_permlane16_swap_b32 v52, v54
    s_nop 0
    v_permlane16_swap_b32 v53, v55
    buffer_store_dwordx4 v[52:55], v10, s[36:39], s72 offen sc1
    v_pk_mul_f32 v[32:33], v[96:97], v[56:57]
    v_pk_mul_f32 v[34:35], v[98:99], v[56:57]
    v_pk_mul_f32 v[36:37], v[100:101], v[56:57]
    v_pk_mul_f32 v[38:39], v[102:103], v[56:57]
    v_exp_f32 v32, v32
    v_exp_f32 v33, v33
    v_exp_f32 v34, v34
    v_exp_f32 v35, v35
    v_exp_f32 v36, v36
    v_exp_f32 v37, v37
    v_exp_f32 v38, v38
    v_exp_f32 v39, v39
    v_pk_add_f32 v[32:33], v[32:33], v[58:59]
    v_pk_add_f32 v[34:35], v[34:35], v[58:59]
    v_pk_add_f32 v[36:37], v[36:37], v[58:59]
    v_pk_add_f32 v[38:39], v[38:39], v[58:59]
    v_rcp_f32 v32, v32
    v_rcp_f32 v33, v33
    v_rcp_f32 v34, v34
    v_rcp_f32 v35, v35
    v_rcp_f32 v36, v36
    v_rcp_f32 v37, v37
    v_rcp_f32 v38, v38
    v_rcp_f32 v39, v39
    v_pk_mul_f32 v[32:33], v[32:33], v[96:97]
    v_pk_mul_f32 v[34:35], v[34:35], v[98:99]
    v_pk_mul_f32 v[36:37], v[36:37], v[100:101]
    v_pk_mul_f32 v[38:39], v[38:39], v[102:103]
    v_pk_mul_f32 v[32:33], v[32:33], v[112:113]
    v_pk_mul_f32 v[34:35], v[34:35], v[114:115]
    v_pk_mul_f32 v[36:37], v[36:37], v[116:117]
    v_pk_mul_f32 v[38:39], v[38:39], v[118:119]
    v_cvt_pk_bf16_f32 v40, v32, v33
    v_cvt_pk_bf16_f32 v42, v36, v37
    v_cvt_pk_bf16_f32 v41, v34, v35
    v_cvt_pk_bf16_f32 v43, v38, v39
    v_permlane16_swap_b32 v40, v42
    s_nop 0
    v_permlane16_swap_b32 v41, v43
    buffer_store_dwordx4 v[40:43], v9, s[36:39], s73 offen sc1
    v_pk_mul_f32 v[44:45], v[104:105], v[56:57]
    v_pk_mul_f32 v[46:47], v[106:107], v[56:57]
    v_pk_mul_f32 v[48:49], v[108:109], v[56:57]
    v_pk_mul_f32 v[50:51], v[110:111], v[56:57]
    v_exp_f32 v44, v44
    v_exp_f32 v45, v45
    v_exp_f32 v46, v46
    v_exp_f32 v47, v47
    v_exp_f32 v48, v48
    v_exp_f32 v49, v49
    v_exp_f32 v50, v50
    v_exp_f32 v51, v51
    v_pk_add_f32 v[44:45], v[44:45], v[58:59]
    v_pk_add_f32 v[46:47], v[46:47], v[58:59]
    v_pk_add_f32 v[48:49], v[48:49], v[58:59]
    v_pk_add_f32 v[50:51], v[50:51], v[58:59]
    v_rcp_f32 v44, v44
    v_rcp_f32 v45, v45
    v_rcp_f32 v46, v46
    v_rcp_f32 v47, v47
    v_rcp_f32 v48, v48
    v_rcp_f32 v49, v49
    v_rcp_f32 v50, v50
    v_rcp_f32 v51, v51
    v_pk_mul_f32 v[44:45], v[44:45], v[104:105]
    v_pk_mul_f32 v[46:47], v[46:47], v[106:107]
    v_pk_mul_f32 v[48:49], v[48:49], v[108:109]
    v_pk_mul_f32 v[50:51], v[50:51], v[110:111]
    v_pk_mul_f32 v[44:45], v[44:45], v[120:121]
    v_pk_mul_f32 v[46:47], v[46:47], v[122:123]
    v_pk_mul_f32 v[48:49], v[48:49], v[124:125]
    v_pk_mul_f32 v[50:51], v[50:51], v[126:127]
    v_cvt_pk_bf16_f32 v52, v44, v45
    v_cvt_pk_bf16_f32 v54, v48, v49
    v_cvt_pk_bf16_f32 v53, v46, v47
    v_cvt_pk_bf16_f32 v55, v50, v51
    v_permlane16_swap_b32 v52, v54
    s_nop 0
    v_permlane16_swap_b32 v53, v55
    buffer_store_dwordx4 v[52:55], v10, s[36:39], s73 offen sc1
    v_pk_mul_f32 v[32:33], v[128:129], v[56:57]
    v_pk_mul_f32 v[34:35], v[130:131], v[56:57]
    v_pk_mul_f32 v[36:37], v[132:133], v[56:57]
    v_pk_mul_f32 v[38:39], v[134:135], v[56:57]
    v_exp_f32 v32, v32
    v_exp_f32 v33, v33
    v_exp_f32 v34, v34
    v_exp_f32 v35, v35
    v_exp_f32 v36, v36
    v_exp_f32 v37, v37
    v_exp_f32 v38, v38
    v_exp_f32 v39, v39
    v_pk_add_f32 v[32:33], v[32:33], v[58:59]
    v_pk_add_f32 v[34:35], v[34:35], v[58:59]
    v_pk_add_f32 v[36:37], v[36:37], v[58:59]
    v_pk_add_f32 v[38:39], v[38:39], v[58:59]
    v_rcp_f32 v32, v32
    v_rcp_f32 v33, v33
    v_rcp_f32 v34, v34
    v_rcp_f32 v35, v35
    v_rcp_f32 v36, v36
    v_rcp_f32 v37, v37
    v_rcp_f32 v38, v38
    v_rcp_f32 v39, v39
    v_pk_mul_f32 v[32:33], v[32:33], v[128:129]
    v_pk_mul_f32 v[34:35], v[34:35], v[130:131]
    v_pk_mul_f32 v[36:37], v[36:37], v[132:133]
    v_pk_mul_f32 v[38:39], v[38:39], v[134:135]
    v_pk_mul_f32 v[32:33], v[32:33], v[144:145]
    v_pk_mul_f32 v[34:35], v[34:35], v[146:147]
    v_pk_mul_f32 v[36:37], v[36:37], v[148:149]
    v_pk_mul_f32 v[38:39], v[38:39], v[150:151]
    v_cvt_pk_bf16_f32 v40, v32, v33
    v_cvt_pk_bf16_f32 v42, v36, v37
    v_cvt_pk_bf16_f32 v41, v34, v35
    v_cvt_pk_bf16_f32 v43, v38, v39
    v_permlane16_swap_b32 v40, v42
    s_nop 0
    v_permlane16_swap_b32 v41, v43
    s_cmp_le_u32 s81, 2
    s_cbranch_scc1 K_c_ns20
    buffer_store_dwordx4 v[40:43], v9, s[36:39], s74 offen sc1
K_c_ns20:
    v_pk_mul_f32 v[44:45], v[136:137], v[56:57]
    v_pk_mul_f32 v[46:47], v[138:139], v[56:57]
    v_pk_mul_f32 v[48:49], v[140:141], v[56:57]
    v_pk_mul_f32 v[50:51], v[142:143], v[56:57]
    v_exp_f32 v44, v44
    v_exp_f32 v45, v45
    v_exp_f32 v46, v46
    v_exp_f32 v47, v47
    v_exp_f32 v48, v48
    v_exp_f32 v49, v49
    v_exp_f32 v50, v50
    v_exp_f32 v51, v51
    v_pk_add_f32 v[44:45], v[44:45], v[58:59]
    v_pk_add_f32 v[46:47], v[46:47], v[58:59]
    v_pk_add_f32 v[48:49], v[48:49], v[58:59]
    v_pk_add_f32 v[50:51], v[50:51], v[58:59]
    v_rcp_f32 v44, v44
    v_rcp_f32 v45, v45
    v_rcp_f32 v46, v46
    v_rcp_f32 v47, v47
    v_rcp_f32 v48, v48
    v_rcp_f32 v49, v49
    v_rcp_f32 v50, v50
    v_rcp_f32 v51, v51
    v_pk_mul_f32 v[44:45], v[44:45], v[136:137]
    v_pk_mul_f32 v[46:47], v[46:47], v[138:139]
    v_pk_mul_f32 v[48:49], v[48:49], v[140:141]
    v_pk_mul_f32 v[50:51], v[50:51], v[142:143]
    v_pk_mul_f32 v[44:45], v[44:45], v[152:153]
    v_pk_mul_f32 v[46:47], v[46:47], v[154:155]
    v_pk_mul_f32 v[48:49], v[48:49], v[156:157]
    v_pk_mul_f32 v[50:51], v[50:51], v[158:159]
    v_cvt_pk_bf16_f32 v52, v44, v45
    v_cvt_pk_bf16_f32 v54, v48, v49
    v_cvt_pk_bf16_f32 v53, v46, v47
    v_cvt_pk_bf16_f32 v55, v50, v51
    v_permlane16_swap_b32 v52, v54
    s_nop 0
    v_permlane16_swap_b32 v53, v55
    s_cmp_le_u32 s81, 2
    s_cbranch_scc1 K_c_ns21
    buffer_store_dwordx4 v[52:55], v10, s[36:39], s74 offen sc1
K_c_ns21:
K_c_epidone:
    s_mov_b64 exec, 1
    ds_add_u32 v22, v23 offset:4
    s_mov_b64 exec, -1
    v_lshrrev_b32 v16, 4, v1
    v_lshrrev_b32 v17, 5, v1
    v_bfe_u32 v18, v1, 2, 2
    v_lshl_add_u32 v17, v17, 3, v18
    v_lshlrev_b32 v17, 7, v17
    v_and_b32 v16, 1, v16
    v_and_b32 v19, 1, v1
    v_lshl_add_u32 v16, v19, 1, v16
    v_lshlrev_b32 v18, 1, v18
    v_and_b32 v18, 4, v18
    s_bfe_u32 s55, s48, 65537
    s_lshl_b32 s56, s55, 2
    v_xor_b32 v18, s56, v18
    v_xor_b32 v16, v16, v18
    v_lshl_add_u32 v17, v16, 4, v17
    v_bfe_u32 v19, v1, 1, 1
    v_lshl_add_u32 v17, v19, 3, v17
    s_lshl_b32 s56, s55, 11
    v_add_u32 v10, s56, v17
    v_xor_b32 v11, 64, v10
    v_add_u32 v12, 65536, v10
    v_add_u32 v13, 65536, v11
    v_add_u32 v14, 131072, v10
    v_add_u32 v15, 131072, v11
    s_waitcnt vmcnt(0)
    s_barrier
K_c_p2:
    ds_read_b64_tr_b16 v[96:97], v10 offset:0
    ds_read_b64_tr_b16 v[98:99], v10 offset:512
    ds_read_b64_tr_b16 v[100:101], v11 offset:0
    ds_read_b64_tr_b16 v[102:103], v11 offset:512
    ds_read_b64_tr_b16 v[104:105], v10 offset:4096
    ds_read_b64_tr_b16 v[106:107], v10 offset:4608
    ds_read_b64_tr_b16 v[108:109], v11 offset:4096
    ds_read_b64_tr_b16 v[110:111], v11 offset:4608
    ds_read_b64_tr_b16 v[112:113], v10 offset:8192
    ds_read_b64_tr_b16 v[114:115], v10 offset:8704
    ds_read_b64_tr_b16 v[116:117], v11 offset:8192
    ds_read_b64_tr_b16 v[118:119], v11 offset:8704
    s_waitcnt lgkmcnt(8)
    ds_read_b64_tr_b16 v[120:121], v10 offset:12288
    ds_read_b64_tr_b16 v[122:123], v10 offset:12800
    ds_read_b64_tr_b16 v[124:125], v11 offset:12288
    ds_read_b64_tr_b16 v[126:127], v11 offset:12800
    s_waitcnt lgkmcnt(0)
    s_barrier
    s_lshl_b32 s55, s50, 1
    s_add_u32 s55, s55, s49
    s_lshl_b32 s55, s55, 1
    s_lshr_b32 s56, s2, 6
    s_add_u32 s53, s55, s56
    s_bfe_u32 s54, s2, 196611
    s_mul_i32 s66, s56, 11
    s_bfe_u32 s55, s48, 65537
    s_and_b32 s56, s48, 1
    s_lshl_b32 s57, s53, 1
    s_add_u32 s56, s56, s57
    s_mul_i32 s57, s56, 87
    s_mul_i32 s58, s55, 43
    s_add_u32 s57, s57, s58
    s_lshl_b32 s80, s57, 10
    s_add_u32 s79, s80, 44032
    s_lshl_b32 s57, s66, 10
    s_add_u32 s78, s80, s57
    v_and_b32 v16, 31, v1
    v_lshlrev_b32 v16, 10, v16
    v_and_b32 v17, 32, v1
    s_lshl_b32 s56, s56, 15
    s_lshl_b32 s57, s54, 7
    s_add_u32 s56, s56, s57
    s_lshl_b32 s57, s55, 6
    s_add_u32 s56, s56, s57
    v_add3_u32 v16, v16, v17, s56
    s_and_b32 s56, s48, 3
    s_lshl_b32 s56, s56, 12
    s_xor_b32 s57, s56, 8192
    s_add_u32 s56, s56, 16384
    s_add_u32 s57, s57, 16384
    v_add_u32 v17, s56, v9
    v_add_u32 v18, s57, v9
    v_and_b32 v25, 31, v1
    s_and_b32 s56, s48, 1
    s_lshl_b32 s56, s56, 12
    s_add_u32 s56, s56, 32768
    v_lshl_add_u32 v26, v25, 7, s56
    v_lshrrev_b32 v27, 5, v1
    s_lshl_b32 s57, s55, 1
    v_add_lshl_u32 v27, v27, s57, 1
    v_and_b32 v25, 7, v25
    v_xor_b32 v27, v27, v25
    v_lshl_add_u32 v25, v27, 4, v26
    v_xor_b32 v26, 16, v25
    v_lshrrev_b32 v27, 2, v1
    v_and_b32 v28, 3, v1
    s_lshl_b32 s57, s55, 2
    v_add_u32 v28, s57, v28
    s_and_b32 s57, s48, 1
    s_lshl_b32 s58, s53, 1
    s_add_u32 s57, s57, s58
    s_lshl_b32 s57, s57, 15
    s_lshl_b32 s58, s54, 7
    s_add_u32 s57, s57, s58
    v_lshl_add_u32 v16, v27, 10, s57
    v_lshl_add_u32 v16, v28, 4, v16
    v_add_u32 v29, 16384, v16
    v_and_b32 v30, 7, v27
    v_xor_b32 v28, v28, v30
    v_lshl_add_u32 v27, v27, 7, s56
    v_lshl_add_u32 v27, v28, 4, v27
    v_mov_b64 v[64:65], 0
    v_mov_b64 v[66:67], 0
    v_mov_b64 v[68:69], 0
    v_mov_b64 v[70:71], 0
    v_mov_b64 v[72:73], 0
    v_mov_b64 v[74:75], 0
    v_mov_b64 v[76:77], 0
    v_mov_b64 v[78:79], 0
    v_mov_b64 v[80:81], 0
    v_mov_b64 v[82:83], 0
    v_mov_b64 v[84:85], 0
    v_mov_b64 v[86:87], 0
    v_mov_b64 v[88:89], 0
    v_mov_b64 v[90:91], 0
    v_mov_b64 v[92:93], 0
    v_mov_b64 v[94:95], 0
    s_branch K_c_spin
.p2align 12
K_c_spin:
    ds_read_b32 v24, v22
    s_waitcnt lgkmcnt(0)
    v_readfirstlane_b32 s55, v24
    s_nop 0
    s_cmp_eq_u32 s55, 0
    s_cbranch_scc1 K_c_spin
    buffer_load_dwordx4 v[160:163], v9, s[36:39], s78 offen sc1
    s_add_u32 s78, s78, 1024
    s_cmp_eq_u32 s78, s79
    s_cselect_b32 s78, s80, s78
    buffer_load_dwordx4 v[164:167], v9, s[36:39], s78 offen sc1
    s_add_u32 s78, s78, 1024
    s_cmp_eq_u32 s78, s79
    s_cselect_b32 s78, s80, s78
    buffer_load_dwordx4 v[168:171], v9, s[36:39], s78 offen sc1
    s_add_u32 s78, s78, 1024
    s_cmp_eq_u32 s78, s79
    s_cselect_b32 s78, s80, s78
    buffer_load_dwordx4 v[172:175], v9, s[36:39], s78 offen sc1
    s_add_u32 s78, s78, 1024
    s_cmp_eq_u32 s78, s79
    s_cselect_b32 s78, s80, s78
    buffer_load_dwordx4 v[176:179], v9, s[36:39], s78 offen sc1
    s_add_u32 s78, s78, 1024
    s_cmp_eq_u32 s78, s79
    s_cselect_b32 s78, s80, s78
    buffer_load_dwordx4 v[180:183], v9, s[36:39], s78 offen sc1
    s_add_u32 s78, s78, 1024
    s_cmp_eq_u32 s78, s79
    s_cselect_b32 s78, s80, s78
    buffer_load_dwordx4 v[184:187], v9, s[36:39], s78 offen sc1
    s_add_u32 s78, s78, 1024
    s_cmp_eq_u32 s78, s79
    s_cselect_b32 s78, s80, s78
    buffer_load_dwordx4 v[188:191], v9, s[36:39], s78 offen sc1
    s_add_u32 s78, s78, 1024
    s_cmp_eq_u32 s78, s79
    s_cselect_b32 s78, s80, s78
    buffer_load_dwordx4 v[192:195], v9, s[36:39], s78 offen sc1
    s_add_u32 s78, s78, 1024
    s_cmp_eq_u32 s78, s79
    s_cselect_b32 s78, s80, s78
    buffer_load_dwordx4 v[196:199], v9, s[36:39], s78 offen sc1
    s_add_u32 s78, s78, 1024
    s_cmp_eq_u32 s78, s79
    s_cselect_b32 s78, s80, s78
    s_waitcnt vmcnt(9) lgkmcnt(0)
    v_mfma_f32_32x32x16_bf16 v[80:95], v[100:103], v[160:163], v[80:95]
    buffer_load_dwordx4 v[200:203], v9, s[36:39], s78 offen sc1
    s_add_u32 s78, s78, 1024
    s_cmp_eq_u32 s78, s79
    s_cselect_b32 s78, s80, s78
    v_mfma_f32_32x32x16_bf16 v[64:79], v[96:99], v[160:163], v[64:79]
    buffer_load_dwordx4 v[204:207], v9, s[36:39], s78 offen sc1
    s_add_u32 s78, s78, 1024
    s_cmp_eq_u32 s78, s79
    s_cselect_b32 s78, s80, s78
    s_waitcnt vmcnt(10) lgkmcnt(0)
    v_mfma_f32_32x32x16_bf16 v[80:95], v[108:111], v[164:167], v[80:95]
    buffer_load_dwordx4 v[160:163], v9, s[36:39], s78 offen sc1
    s_add_u32 s78, s78, 1024
    s_cmp_eq_u32 s78, s79
    s_cselect_b32 s78, s80, s78
    v_mfma_f32_32x32x16_bf16 v[64:79], v[104:107], v[164:167], v[64:79]
    s_waitcnt vmcnt(10) lgkmcnt(0)
    v_mfma_f32_32x32x16_bf16 v[80:95], v[116:119], v[168:171], v[80:95]
    ds_read_b64_tr_b16 v[136:137], v10 offset:16384
    ds_read_b64_tr_b16 v[138:139], v10 offset:16896
    buffer_load_dwordx4 v[164:167], v9, s[36:39], s78 offen sc1
    s_add_u32 s78, s78, 1024
    s_cmp_eq_u32 s78, s79
    s_cselect_b32 s78, s80, s78
    v_mfma_f32_32x32x16_bf16 v[64:79], v[112:115], v[168:171], v[64:79]
    ds_read_b64_tr_b16 v[140:141], v11 offset:16384
    ds_read_b64_tr_b16 v[142:143], v11 offset:16896
    s_waitcnt vmcnt(10) lgkmcnt(4)
    v_mfma_f32_32x32x16_bf16 v[80:95], v[124:127], v[172:175], v[80:95]
    ds_read_b64_tr_b16 v[144:145], v10 offset:20480
    ds_read_b64_tr_b16 v[146:147], v10 offset:20992
    buffer_load_dwordx4 v[168:171], v9, s[36:39], s78 offen sc1
    s_add_u32 s78, s78, 1024
    s_cmp_eq_u32 s78, s79
    s_cselect_b32 s78, s80, s78
    v_mfma_f32_32x32x16_bf16 v[64:79], v[120:123], v[172:175], v[64:79]
    ds_read_b64_tr_b16 v[148:149], v11 offset:20480
    ds_read_b64_tr_b16 v[150:151], v11 offset:20992
    s_waitcnt vmcnt(10) lgkmcnt(4)
    v_mfma_f32_32x32x16_bf16 v[80:95], v[140:143], v[176:179], v[80:95]
    ds_read_b64_tr_b16 v[128:129], v10 offset:24576
    ds_read_b64_tr_b16 v[130:131], v10 offset:25088
    buffer_load_dwordx4 v[172:175], v9, s[36:39], s78 offen sc1
    s_add_u32 s78, s78, 1024
    s_cmp_eq_u32 s78, s79
    s_cselect_b32 s78, s80, s78
    v_mfma_f32_32x32x16_bf16 v[64:79], v[136:139], v[176:179], v[64:79]
    ds_read_b64_tr_b16 v[132:133], v11 offset:24576
    ds_read_b64_tr_b16 v[134:135], v11 offset:25088
    s_waitcnt vmcnt(10) lgkmcnt(4)
    v_mfma_f32_32x32x16_bf16 v[80:95], v[148:151], v[180:183], v[80:95]
    ds_read_b64_tr_b16 v[136:137], v10 offset:28672
    ds_read_b64_tr_b16 v[138:139], v10 offset:29184
    buffer_load_dwordx4 v[176:179], v9, s[36:39], s78 offen sc1
    s_add_u32 s78, s78, 1024
    s_cmp_eq_u32 s78, s79
    s_cselect_b32 s78, s80, s78
    v_mfma_f32_32x32x16_bf16 v[64:79], v[144:147], v[180:183], v[64:79]
    ds_read_b64_tr_b16 v[140:141], v11 offset:28672
    ds_read_b64_tr_b16 v[142:143], v11 offset:29184
    s_waitcnt vmcnt(10) lgkmcnt(4)
    v_mfma_f32_32x32x16_bf16 v[80:95], v[132:135], v[184:187], v[80:95]
    ds_read_b64_tr_b16 v[144:145], v10 offset:32768
    ds_read_b64_tr_b16 v[146:147], v10 offset:33280
    buffer_load_dwordx4 v[180:183], v9, s[36:39], s78 offen sc1
    s_add_u32 s78, s78, 1024
    s_cmp_eq_u32 s78, s79
    s_cselect_b32 s78, s80, s78
    v_mfma_f32_32x32x16_bf16 v[64:79], v[128:131], v[184:187], v[64:79]
    ds_read_b64_tr_b16 v[148:149], v11 offset:32768
    ds_read_b64_tr_b16 v[150:151], v11 offset:33280
    s_waitcnt vmcnt(10) lgkmcnt(4)
    v_mfma_f32_32x32x16_bf16 v[80:95], v[140:143], v[188:191], v[80:95]
    ds_read_b64_tr_b16 v[128:129], v10 offset:36864
    ds_read_b64_tr_b16 v[130:131], v10 offset:37376
    buffer_load_dwordx4 v[184:187], v9, s[36:39], s78 offen sc1
    s_add_u32 s78, s78, 1024
    s_cmp_eq_u32 s78, s79
    s_cselect_b32 s78, s80, s78
    v_mfma_f32_32x32x16_bf16 v[64:79], v[136:139], v[188:191], v[64:79]
    ds_read_b64_tr_b16 v[132:133], v11 offset:36864
    ds_read_b64_tr_b16 v[134:135], v11 offset:37376
    s_waitcnt vmcnt(10) lgkmcnt(4)
    v_mfma_f32_32x32x16_bf16 v[80:95], v[148:151], v[192:195], v[80:95]
    ds_read_b64_tr_b16 v[136:137], v10 offset:40960
    ds_read_b64_tr_b16 v[138:139], v10 offset:41472
    buffer_load_dwordx4 v[188:191], v9, s[36:39], s78 offen sc1
    s_add_u32 s78, s78, 1024
    s_cmp_eq_u32 s78, s79
    s_cselect_b32 s78, s80, s78
    v_mfma_f32_32x32x16_bf16 v[64:79], v[144:147], v[192:195], v[64:79]
    ds_read_b64_tr_b16 v[140:141], v11 offset:40960
    ds_read_b64_tr_b16 v[142:143], v11 offset:41472
    s_waitcnt vmcnt(10) lgkmcnt(4)
    v_mfma_f32_32x32x16_bf16 v[80:95], v[132:135], v[196:199], v[80:95]
    ds_read_b64_tr_b16 v[144:145], v10 offset:45056
    ds_read_b64_tr_b16 v[146:147], v10 offset:45568
    buffer_load_dwordx4 v[192:195], v9, s[36:39], s78 offen sc1
    s_add_u32 s78, s78, 1024
    s_cmp_eq_u32 s78, s79
    s_cselect_b32 s78, s80, s78
    v_mfma_f32_32x32x16_bf16 v[64:79], v[128:131], v[196:199], v[64:79]
    ds_read_b64_tr_b16 v[148:149], v11 offset:45056
    ds_read_b64_tr_b16 v[150:151], v11 offset:45568
    s_waitcnt vmcnt(10) lgkmcnt(4)
    v_mfma_f32_32x32x16_bf16 v[80:95], v[140:143], v[200:203], v[80:95]
    ds_read_b64_tr_b16 v[128:129], v10 offset:49152
    ds_read_b64_tr_b16 v[130:131], v10 offset:49664
    buffer_load_dwordx4 v[196:199], v9, s[36:39], s78 offen sc1
    s_add_u32 s78, s78, 1024
    s_cmp_eq_u32 s78, s79
    s_cselect_b32 s78, s80, s78
    v_mfma_f32_32x32x16_bf16 v[64:79], v[136:139], v[200:203], v[64:79]
    ds_read_b64_tr_b16 v[132:133], v11 offset:49152
    ds_read_b64_tr_b16 v[134:135], v11 offset:49664
    s_waitcnt vmcnt(10) lgkmcnt(4)
    v_mfma_f32_32x32x16_bf16 v[80:95], v[148:151], v[204:207], v[80:95]
    ds_read_b64_tr_b16 v[136:137], v10 offset:53248
    ds_read_b64_tr_b16 v[138:139], v10 offset:53760
    buffer_load_dwordx4 v[200:203], v9, s[36:39], s78 offen sc1
    s_add_u32 s78, s78, 1024
    s_cmp_eq_u32 s78, s79
    s_cselect_b32 s78, s80, s78
    v_mfma_f32_32x32x16_bf16 v[64:79], v[144:147], v[204:207], v[64:79]
    ds_read_b64_tr_b16 v[140:141], v11 offset:53248
    ds_read_b64_tr_b16 v[142:143], v11 offset:53760
    s_waitcnt vmcnt(10) lgkmcnt(4)
    v_mfma_f32_32x32x16_bf16 v[80:95], v[132:135], v[160:163], v[80:95]
    ds_read_b64_tr_b16 v[144:145], v10 offset:57344
    ds_read_b64_tr_b16 v[146:147], v10 offset:57856
    buffer_load_dwordx4 v[204:207], v9, s[36:39], s78 offen sc1
    s_add_u32 s78, s78, 1024
    s_cmp_eq_u32 s78, s79
    s_cselect_b32 s78, s80, s78
    v_mfma_f32_32x32x16_bf16 v[64:79], v[128:131], v[160:163], v[64:79]
    ds_read_b64_tr_b16 v[148:149], v11 offset:57344
    ds_read_b64_tr_b16 v[150:151], v11 offset:57856
    s_waitcnt vmcnt(10) lgkmcnt(4)
    v_mfma_f32_32x32x16_bf16 v[80:95], v[140:143], v[164:167], v[80:95]
    ds_read_b64_tr_b16 v[128:129], v10 offset:61440
    ds_read_b64_tr_b16 v[130:131], v10 offset:61952
    buffer_load_dwordx4 v[160:163], v9, s[36:39], s78 offen sc1
    s_add_u32 s78, s78, 1024
    s_cmp_eq_u32 s78, s79
    s_cselect_b32 s78, s80, s78
    v_mfma_f32_32x32x16_bf16 v[64:79], v[136:139], v[164:167], v[64:79]
    ds_read_b64_tr_b16 v[132:133], v11 offset:61440
    ds_read_b64_tr_b16 v[134:135], v11 offset:61952
    s_waitcnt vmcnt(10) lgkmcnt(4)
    v_mfma_f32_32x32x16_bf16 v[80:95], v[148:151], v[168:171], v[80:95]
    ds_read_b64_tr_b16 v[136:137], v12 offset:0
    ds_read_b64_tr_b16 v[138:139], v12 offset:512
    buffer_load_dwordx4 v[164:167], v9, s[36:39], s78 offen sc1
    s_add_u32 s78, s78, 1024
    s_cmp_eq_u32 s78, s79
    s_cselect_b32 s78, s80, s78
    v_mfma_f32_32x32x16_bf16 v[64:79], v[144:147], v[168:171], v[64:79]
    ds_read_b64_tr_b16 v[140:141], v13 offset:0
    ds_read_b64_tr_b16 v[142:143], v13 offset:512
    s_waitcnt vmcnt(10) lgkmcnt(4)
    v_mfma_f32_32x32x16_bf16 v[80:95], v[132:135], v[172:175], v[80:95]
    ds_read_b64_tr_b16 v[144:145], v12 offset:4096
    ds_read_b64_tr_b16 v[146:147], v12 offset:4608
    buffer_load_dwordx4 v[168:171], v9, s[36:39], s78 offen sc1
    s_add_u32 s78, s78, 1024
    s_cmp_eq_u32 s78, s79
    s_cselect_b32 s78, s80, s78
    v_mfma_f32_32x32x16_bf16 v[64:79], v[128:131], v[172:175], v[64:79]
    ds_read_b64_tr_b16 v[148:149], v13 offset:4096
    ds_read_b64_tr_b16 v[150:151], v13 offset:4608
    s_waitcnt vmcnt(10) lgkmcnt(4)
    v_mfma_f32_32x32x16_bf16 v[80:95], v[140:143], v[176:179], v[80:95]
    ds_read_b64_tr_b16 v[128:129], v12 offset:8192
    ds_read_b64_tr_b16 v[130:131], v12 offset:8704
    buffer_load_dwordx4 v[172:175], v9, s[36:39], s78 offen sc1
    s_add_u32 s78, s78, 1024
    s_cmp_eq_u32 s78, s79
    s_cselect_b32 s78, s80, s78
    v_mfma_f32_32x32x16_bf16 v[64:79], v[136:139], v[176:179], v[64:79]
    ds_read_b64_tr_b16 v[132:133], v13 offset:8192
    ds_read_b64_tr_b16 v[134:135], v13 offset:8704
    s_waitcnt vmcnt(10) lgkmcnt(4)
    v_mfma_f32_32x32x16_bf16 v[80:95], v[148:151], v[180:183], v[80:95]
    ds_read_b64_tr_b16 v[136:137], v12 offset:12288
    ds_read_b64_tr_b16 v[138:139], v12 offset:12800
    buffer_load_dwordx4 v[176:179], v9, s[36:39], s78 offen sc1
    s_add_u32 s78, s78, 1024
    s_cmp_eq_u32 s78, s79
    s_cselect_b32 s78, s80, s78
    v_mfma_f32_32x32x16_bf16 v[64:79], v[144:147], v[180:183], v[64:79]
    ds_read_b64_tr_b16 v[140:141], v13 offset:12288
    ds_read_b64_tr_b16 v[142:143], v13 offset:12800
    s_waitcnt vmcnt(10) lgkmcnt(4)
    s_barrier
    v_mfma_f32_32x32x16_bf16 v[80:95], v[132:135], v[184:187], v[80:95]
    ds_read_b64_tr_b16 v[144:145], v12 offset:16384
    ds_read_b64_tr_b16 v[146:147], v12 offset:16896
    buffer_load_dwordx4 v[180:183], v9, s[36:39], s78 offen sc1
    s_add_u32 s78, s78, 1024
    s_cmp_eq_u32 s78, s79
    s_cselect_b32 s78, s80, s78
    v_mfma_f32_32x32x16_bf16 v[64:79], v[128:131], v[184:187], v[64:79]
    ds_read_b64_tr_b16 v[148:149], v13 offset:16384
    ds_read_b64_tr_b16 v[150:151], v13 offset:16896
    s_waitcnt vmcnt(10) lgkmcnt(4)
    v_mfma_f32_32x32x16_bf16 v[80:95], v[140:143], v[188:191], v[80:95]
    ds_read_b64_tr_b16 v[128:129], v12 offset:20480
    ds_read_b64_tr_b16 v[130:131], v12 offset:20992
    buffer_load_dwordx4 v[184:187], v9, s[36:39], s78 offen sc1
    s_add_u32 s78, s78, 1024
    s_cmp_eq_u32 s78, s79
    s_cselect_b32 s78, s80, s78
    v_mfma_f32_32x32x16_bf16 v[64:79], v[136:139], v[188:191], v[64:79]
    ds_read_b64_tr_b16 v[132:133], v13 offset:20480
    ds_read_b64_tr_b16 v[134:135], v13 offset:20992
    s_waitcnt vmcnt(10) lgkmcnt(4)
    v_mfma_f32_32x32x16_bf16 v[80:95], v[148:151], v[192:195], v[80:95]
    ds_read_b64_tr_b16 v[136:137], v12 offset:24576
    ds_read_b64_tr_b16 v[138:139], v12 offset:25088
    buffer_load_dwordx4 v[188:191], v9, s[36:39], s78 offen sc1
    s_add_u32 s78, s78, 1024
    s_cmp_eq_u32 s78, s79
    s_cselect_b32 s78, s80, s78
    v_mfma_f32_32x32x16_bf16 v[64:79], v[144:147], v[192:195], v[64:79]
    ds_read_b64_tr_b16 v[140:141], v13 offset:24576
    ds_read_b64_tr_b16 v[142:143], v13 offset:25088
    s_waitcnt vmcnt(10) lgkmcnt(4)
    v_mfma_f32_32x32x16_bf16 v[80:95], v[132:135], v[196:199], v[80:95]
    ds_read_b64_tr_b16 v[144:145], v12 offset:28672
    ds_read_b64_tr_b16 v[146:147], v12 offset:29184
    buffer_load_dwordx4 v[192:195], v9, s[36:39], s78 offen sc1
    s_add_u32 s78, s78, 1024
    s_cmp_eq_u32 s78, s79
    s_cselect_b32 s78, s80, s78
    v_mfma_f32_32x32x16_bf16 v[64:79], v[128:131], v[196:199], v[64:79]
    ds_read_b64_tr_b16 v[148:149], v13 offset:28672
    ds_read_b64_tr_b16 v[150:151], v13 offset:29184
    s_waitcnt vmcnt(10) lgkmcnt(4)
    v_mfma_f32_32x32x16_bf16 v[80:95], v[140:143], v[200:203], v[80:95]
    ds_read_b64_tr_b16 v[128:129], v12 offset:32768
    ds_read_b64_tr_b16 v[130:131], v12 offset:33280
    buffer_load_dwordx4 v[196:199], v9, s[36:39], s78 offen sc1
    s_add_u32 s78, s78, 1024
    s_cmp_eq_u32 s78, s79
    s_cselect_b32 s78, s80, s78
    v_mfma_f32_32x32x16_bf16 v[64:79], v[136:139], v[200:203], v[64:79]
    ds_read_b64_tr_b16 v[132:133], v13 offset:32768
    ds_read_b64_tr_b16 v[134:135], v13 offset:33280
    s_waitcnt vmcnt(10) lgkmcnt(4)
    v_mfma_f32_32x32x16_bf16 v[80:95], v[148:151], v[204:207], v[80:95]
    ds_read_b64_tr_b16 v[136:137], v12 offset:36864
    ds_read_b64_tr_b16 v[138:139], v12 offset:37376
    buffer_load_dwordx4 v[200:203], v9, s[36:39], s78 offen sc1
    s_add_u32 s78, s78, 1024
    s_cmp_eq_u32 s78, s79
    s_cselect_b32 s78, s80, s78
    v_mfma_f32_32x32x16_bf16 v[64:79], v[144:147], v[204:207], v[64:79]
    ds_read_b64_tr_b16 v[140:141], v13 offset:36864
    ds_read_b64_tr_b16 v[142:143], v13 offset:37376
    s_waitcnt vmcnt(10) lgkmcnt(4)
    v_mfma_f32_32x32x16_bf16 v[80:95], v[132:135], v[160:163], v[80:95]
    ds_read_b64_tr_b16 v[144:145], v12 offset:40960
    ds_read_b64_tr_b16 v[146:147], v12 offset:41472
    buffer_load_dwordx4 v[204:207], v9, s[36:39], s78 offen sc1
    s_add_u32 s78, s78, 1024
    s_cmp_eq_u32 s78, s79
    s_cselect_b32 s78, s80, s78
    v_mfma_f32_32x32x16_bf16 v[64:79], v[128:131], v[160:163], v[64:79]
    ds_read_b64_tr_b16 v[148:149], v13 offset:40960
    ds_read_b64_tr_b16 v[150:151], v13 offset:41472
    s_waitcnt vmcnt(10) lgkmcnt(4)
    v_mfma_f32_32x32x16_bf16 v[80:95], v[140:143], v[164:167], v[80:95]
    ds_read_b64_tr_b16 v[128:129], v12 offset:45056
    ds_read_b64_tr_b16 v[130:131], v12 offset:45568
    buffer_load_dwordx4 v[160:163], v9, s[36:39], s78 offen sc1
    s_add_u32 s78, s78, 1024
    s_cmp_eq_u32 s78, s79
    s_cselect_b32 s78, s80, s78
    v_mfma_f32_32x32x16_bf16 v[64:79], v[136:139], v[164:167], v[64:79]
    ds_read_b64_tr_b16 v[132:133], v13 offset:45056
    ds_read_b64_tr_b16 v[134:135], v13 offset:45568
    s_waitcnt vmcnt(10) lgkmcnt(4)
    v_mfma_f32_32x32x16_bf16 v[80:95], v[148:151], v[168:171], v[80:95]
    ds_read_b64_tr_b16 v[136:137], v12 offset:49152
    ds_read_b64_tr_b16 v[138:139], v12 offset:49664
    buffer_load_dwordx4 v[164:167], v9, s[36:39], s78 offen sc1
    s_add_u32 s78, s78, 1024
    s_cmp_eq_u32 s78, s79
    s_cselect_b32 s78, s80, s78
    v_mfma_f32_32x32x16_bf16 v[64:79], v[144:147], v[168:171], v[64:79]
    ds_read_b64_tr_b16 v[140:141], v13 offset:49152
    ds_read_b64_tr_b16 v[142:143], v13 offset:49664
    s_waitcnt vmcnt(10) lgkmcnt(4)
    v_mfma_f32_32x32x16_bf16 v[80:95], v[132:135], v[172:175], v[80:95]
    ds_read_b64_tr_b16 v[144:145], v12 offset:53248
    ds_read_b64_tr_b16 v[146:147], v12 offset:53760
    buffer_load_dwordx4 v[168:171], v9, s[36:39], s78 offen sc1
    s_add_u32 s78, s78, 1024
    s_cmp_eq_u32 s78, s79
    s_cselect_b32 s78, s80, s78
    v_mfma_f32_32x32x16_bf16 v[64:79], v[128:131], v[172:175], v[64:79]
    ds_read_b64_tr_b16 v[148:149], v13 offset:53248
    ds_read_b64_tr_b16 v[150:151], v13 offset:53760
    s_waitcnt vmcnt(10) lgkmcnt(4)
    v_mfma_f32_32x32x16_bf16 v[80:95], v[140:143], v[176:179], v[80:95]
    ds_read_b64_tr_b16 v[128:129], v12 offset:57344
    ds_read_b64_tr_b16 v[130:131], v12 offset:57856
    buffer_load_dwordx4 v[172:175], v9, s[36:39], s78 offen sc1
    s_add_u32 s78, s78, 1024
    s_cmp_eq_u32 s78, s79
    s_cselect_b32 s78, s80, s78
    v_mfma_f32_32x32x16_bf16 v[64:79], v[136:139], v[176:179], v[64:79]
    ds_read_b64_tr_b16 v[132:133], v13 offset:57344
    ds_read_b64_tr_b16 v[134:135], v13 offset:57856
    s_waitcnt vmcnt(10) lgkmcnt(4)
    v_mfma_f32_32x32x16_bf16 v[80:95], v[148:151], v[180:183], v[80:95]
    ds_read_b64_tr_b16 v[136:137], v12 offset:61440
    ds_read_b64_tr_b16 v[138:139], v12 offset:61952
    buffer_load_dwordx4 v[176:179], v9, s[36:39], s78 offen sc1
    s_add_u32 s78, s78, 1024
    s_cmp_eq_u32 s78, s79
    s_cselect_b32 s78, s80, s78
    v_mfma_f32_32x32x16_bf16 v[64:79], v[144:147], v[180:183], v[64:79]
    ds_read_b64_tr_b16 v[140:141], v13 offset:61440
    ds_read_b64_tr_b16 v[142:143], v13 offset:61952
    s_waitcnt vmcnt(10) lgkmcnt(4)
    v_mfma_f32_32x32x16_bf16 v[80:95], v[132:135], v[184:187], v[80:95]
    ds_read_b64_tr_b16 v[144:145], v14 offset:0
    ds_read_b64_tr_b16 v[146:147], v14 offset:512
    buffer_load_dwordx4 v[180:183], v9, s[36:39], s78 offen sc1
    s_add_u32 s78, s78, 1024
    s_cmp_eq_u32 s78, s79
    s_cselect_b32 s78, s80, s78
    v_mfma_f32_32x32x16_bf16 v[64:79], v[128:131], v[184:187], v[64:79]
    ds_read_b64_tr_b16 v[148:149], v15 offset:0
    ds_read_b64_tr_b16 v[150:151], v15 offset:512
    s_waitcnt vmcnt(10) lgkmcnt(4)
    v_mfma_f32_32x32x16_bf16 v[80:95], v[140:143], v[188:191], v[80:95]
    ds_read_b64_tr_b16 v[128:129], v14 offset:4096
    ds_read_b64_tr_b16 v[130:131], v14 offset:4608
    buffer_load_dwordx4 v[184:187], v9, s[36:39], s78 offen sc1
    s_add_u32 s78, s78, 1024
    s_cmp_eq_u32 s78, s79
    s_cselect_b32 s78, s80, s78
    v_mfma_f32_32x32x16_bf16 v[64:79], v[136:139], v[188:191], v[64:79]
    ds_read_b64_tr_b16 v[132:133], v15 offset:4096
    ds_read_b64_tr_b16 v[134:135], v15 offset:4608
    s_waitcnt vmcnt(10) lgkmcnt(4)
    v_mfma_f32_32x32x16_bf16 v[80:95], v[148:151], v[192:195], v[80:95]
    ds_read_b64_tr_b16 v[136:137], v14 offset:8192
    ds_read_b64_tr_b16 v[138:139], v14 offset:8704
    v_mfma_f32_32x32x16_bf16 v[64:79], v[144:147], v[192:195], v[64:79]
    ds_read_b64_tr_b16 v[140:141], v15 offset:8192
    ds_read_b64_tr_b16 v[142:143], v15 offset:8704
    s_waitcnt vmcnt(9) lgkmcnt(4)
    v_mfma_f32_32x32x16_bf16 v[80:95], v[132:135], v[196:199], v[80:95]
    ds_read_b64_tr_b16 v[144:145], v14 offset:12288
    ds_read_b64_tr_b16 v[146:147], v14 offset:12800
    v_mfma_f32_32x32x16_bf16 v[64:79], v[128:131], v[196:199], v[64:79]
    ds_read_b64_tr_b16 v[148:149], v15 offset:12288
    ds_read_b64_tr_b16 v[150:151], v15 offset:12800
    s_waitcnt vmcnt(8) lgkmcnt(4)
    v_mfma_f32_32x32x16_bf16 v[80:95], v[140:143], v[200:203], v[80:95]
    ds_read_b64_tr_b16 v[128:129], v14 offset:16384
    ds_read_b64_tr_b16 v[130:131], v14 offset:16896
    v_mfma_f32_32x32x16_bf16 v[64:79], v[136:139], v[200:203], v[64:79]
    ds_read_b64_tr_b16 v[132:133], v15 offset:16384
    ds_read_b64_tr_b16 v[134:135], v15 offset:16896
    s_waitcnt vmcnt(7) lgkmcnt(4)
    v_mfma_f32_32x32x16_bf16 v[80:95], v[148:151], v[204:207], v[80:95]
    ds_read_b64_tr_b16 v[136:137], v14 offset:20480
    ds_read_b64_tr_b16 v[138:139], v14 offset:20992
    v_mfma_f32_32x32x16_bf16 v[64:79], v[144:147], v[204:207], v[64:79]
    ds_read_b64_tr_b16 v[140:141], v15 offset:20480
    ds_read_b64_tr_b16 v[142:143], v15 offset:20992
    s_waitcnt vmcnt(6) lgkmcnt(4)
    v_mfma_f32_32x32x16_bf16 v[80:95], v[132:135], v[160:163], v[80:95]
    ds_read_b64_tr_b16 v[144:145], v14 offset:24576
    ds_read_b64_tr_b16 v[146:147], v14 offset:25088
    v_mfma_f32_32x32x16_bf16 v[64:79], v[128:131], v[160:163], v[64:79]
    ds_read_b64_tr_b16 v[148:149], v15 offset:24576
    ds_read_b64_tr_b16 v[150:151], v15 offset:25088
    s_waitcnt vmcnt(5) lgkmcnt(4)
    v_mfma_f32_32x32x16_bf16 v[80:95], v[140:143], v[164:167], v[80:95]
    ds_read_b64_tr_b16 v[128:129], v10 offset:0
    ds_read_b64_tr_b16 v[130:131], v10 offset:512
    v_mfma_f32_32x32x16_bf16 v[64:79], v[136:139], v[164:167], v[64:79]
    ds_read_b64_tr_b16 v[132:133], v11 offset:0
    ds_read_b64_tr_b16 v[134:135], v11 offset:512
    s_waitcnt vmcnt(4) lgkmcnt(4)
    v_mfma_f32_32x32x16_bf16 v[80:95], v[148:151], v[168:171], v[80:95]
    ds_read_b64_tr_b16 v[96:97], v10 offset:4096
    ds_read_b64_tr_b16 v[98:99], v10 offset:4608
    v_mfma_f32_32x32x16_bf16 v[64:79], v[144:147], v[168:171], v[64:79]
    ds_read_b64_tr_b16 v[100:101], v11 offset:4096
    ds_read_b64_tr_b16 v[102:103], v11 offset:4608
    s_waitcnt vmcnt(3) lgkmcnt(4)
    v_mfma_f32_32x32x16_bf16 v[80:95], v[132:135], v[172:175], v[80:95]
    ds_read_b64_tr_b16 v[104:105], v10 offset:8192
    ds_read_b64_tr_b16 v[106:107], v10 offset:8704
    v_mfma_f32_32x32x16_bf16 v[64:79], v[128:131], v[172:175], v[64:79]
    ds_read_b64_tr_b16 v[108:109], v11 offset:8192
    ds_read_b64_tr_b16 v[110:111], v11 offset:8704
    s_waitcnt vmcnt(2) lgkmcnt(4)
    v_mfma_f32_32x32x16_bf16 v[80:95], v[100:103], v[176:179], v[80:95]
    ds_read_b64_tr_b16 v[112:113], v10 offset:12288
    ds_read_b64_tr_b16 v[114:115], v10 offset:12800
    ds_read_b64_tr_b16 v[116:117], v11 offset:12288
    ds_read_b64_tr_b16 v[118:119], v11 offset:12800
    s_waitcnt vmcnt(1) lgkmcnt(4)
    v_mfma_f32_32x32x16_bf16 v[80:95], v[108:111], v[180:183], v[80:95]
    s_waitcnt vmcnt(0) lgkmcnt(0)
    v_mfma_f32_32x32x16_bf16 v[80:95], v[116:119], v[184:187], v[80:95]
    v_mfma_f32_32x32x16_bf16 v[64:79], v[96:99], v[176:179], v[64:79]
    s_nop 7
    s_nop 3
    ds_write_b128 v17, v[80:83] offset:0
    ds_write_b128 v17, v[84:87] offset:1024
    v_mfma_f32_32x32x16_bf16 v[64:79], v[104:107], v[180:183], v[64:79]
    ds_write_b128 v17, v[88:91] offset:2048
    ds_write_b128 v17, v[92:95] offset:3072
    v_mfma_f32_32x32x16_bf16 v[64:79], v[112:115], v[184:187], v[64:79]
    s_waitcnt lgkmcnt(0)
    s_barrier
    ds_read_b128 v[128:131], v18 offset:0
    ds_read_b128 v[132:135], v18 offset:1024
    ds_read_b128 v[136:139], v18 offset:2048
    ds_read_b128 v[140:143], v18 offset:3072
    s_nop 5
    s_waitcnt lgkmcnt(3)
    v_pk_add_f32 v[64:65], v[64:65], v[128:129]
    v_pk_add_f32 v[66:67], v[66:67], v[130:131]
    v_cvt_pk_bf16_f32 v144, v64, v65
    v_cvt_pk_bf16_f32 v145, v66, v67
    s_waitcnt lgkmcnt(2)
    v_pk_add_f32 v[68:69], v[68:69], v[132:133]
    v_pk_add_f32 v[70:71], v[70:71], v[134:135]
    v_cvt_pk_bf16_f32 v146, v68, v69
    v_cvt_pk_bf16_f32 v147, v70, v71
    ds_write_b128 v25, v[144:147]
    s_waitcnt lgkmcnt(2)
    v_pk_add_f32 v[72:73], v[72:73], v[136:137]
    v_pk_add_f32 v[74:75], v[74:75], v[138:139]
    v_cvt_pk_bf16_f32 v148, v72, v73
    v_cvt_pk_bf16_f32 v149, v74, v75
    s_waitcnt lgkmcnt(1)
    v_pk_add_f32 v[76:77], v[76:77], v[140:141]
    v_pk_add_f32 v[78:79], v[78:79], v[142:143]
    v_cvt_pk_bf16_f32 v150, v76, v77
    v_cvt_pk_bf16_f32 v151, v78, v79
    ds_write_b128 v26, v[148:151]
    ds_read_b128 v[152:155], v27
    ds_read_b128 v[156:159], v27 offset:2048
    s_waitcnt lgkmcnt(1)
    buffer_store_dwordx4 v[152:155], v16, s[40:43], 0 offen sc1
    s_waitcnt lgkmcnt(0)
    buffer_store_dwordx4 v[156:159], v29, s[40:43], 0 offen sc1
    s_endpgm
K_codeend:
.section .rodata,"a"
.p2align 6
.amdhsa_kernel standalone__glu_gated_swiglu__prompt_kernel
  .amdhsa_next_free_vgpr 256
  .amdhsa_next_free_sgpr 102
  .amdhsa_accum_offset 256
  .amdhsa_group_segment_fixed_size 0
  .amdhsa_kernarg_size 56
  .amdhsa_user_sgpr_count 2
  .amdhsa_user_sgpr_kernarg_segment_ptr 1
  .amdhsa_system_sgpr_workgroup_id_x 1
  .amdhsa_float_denorm_mode_32 3
.end_amdhsa_kernel
```
